```python
import torch

def _softmax(x, axis=-1):
    return torch.softmax(x, dim=axis)
def _gelu(x):
    return torch.nn.functional.gelu(x, approximate="tanh")
def _silu(x):
    return torch.nn.functional.silu(x)
def _sigmoid(x):
    return torch.sigmoid(x)
def _layernorm(x, axis=-1, eps=1e-5):
    m = x.mean(dim=axis, keepdim=True)
    v = x.var(dim=axis, keepdim=True, unbiased=False)
    return (x - m) / torch.sqrt(v + eps)
def _scatter_add(tgt, idx, src, axis=0):
    return tgt.clone().index_add_(axis, idx, src)
def _segment_sum(src, seg, n):
    out = torch.zeros((n,) + src.shape[1:], dtype=src.dtype)
    return out.index_add_(0, seg, src)
def _pad(x, pw):
    flat = tuple(v for pair in reversed(pw) for v in pair)
    return torch.nn.functional.pad(x, flat)

kernel_name = 'standalone__gqa_softmax__sampling'

def setup_inputs():

    _w = (lambda a: (lambda t: t.to(torch.bfloat16) if t.is_floating_point() else t)(torch.as_tensor(a)))
    B, Hq, Hkv, Sq, Sk, D = 8, 32, 8, 16, 8192, 128
    return {
        "q": _w((lambda *s: torch.randn(*s, dtype=torch.bfloat16) * 0.8)(B, Hq, Sq, D)),
        "k": _w((lambda *s: torch.randn(*s, dtype=torch.bfloat16) * 0.8)(B, Hkv, Sk, D)),
        "v": _w((lambda *s: torch.randn(*s, dtype=torch.bfloat16) * 0.05)(B, Hkv, Sk, D)),
    }

def reference(q, k, v):
    B, Hq, Sq, D = q.shape
    Hkv = k.shape[1]
    rep = Hq // Hkv
    k = (lambda x, n, axis: torch.repeat_interleave(x, n, dim=axis))(k, rep, axis=1)
    v = (lambda x, n, axis: torch.repeat_interleave(x, n, dim=axis))(v, rep, axis=1)
    scale = D ** -0.5
    scores = torch.einsum("bhqd,bhkd->bhqk", q, k) * scale
    p = _softmax(scores, axis=-1)
    return torch.einsum("bhqk,bhkd->bhqd", p, v)
```

```asm
; @launch grid=(256,1,1) block=(256,1,1) lds=139456
.amdgcn_target "amdgcn-amd-amdhsa--gfx950"
.text
.globl standalone__gqa_softmax__sampling_kernel
.p2align 8
.type standalone__gqa_softmax__sampling_kernel,@function
standalone__gqa_softmax__sampling_kernel:
    s_cmp_ge_u32 s2, 256
    s_cbranch_scc1 L_done
    s_load_dwordx8 s[4:11], s[0:1], 0
    s_load_dwordx4 s[12:15], s[0:1], 32
    v_lshrrev_b32 v1, 6, v0
    v_and_b32 v0, 63, v0
    v_readfirstlane_b32 s40, v1
    v_and_b32 v2, 15, v0
    v_lshrrev_b32 v3, 4, v0
    v_xor_b32 v4, v2, v3
    v_lshlrev_b32 v4, 4, v4
    v_lshlrev_b32 v5, 12, v1
    v_lshl_or_b32 v5, v3, 8, v5
    v_or_b32 v8, v5, v4
    v_xor_b32 v9, 64, v8
    v_xor_b32 v10, 128, v8
    v_xor_b32 v11, 192, v8
    v_lshlrev_b32 v6, 1, v3
    v_xor_b32 v6, v6, v2
    v_lshl_or_b32 v12, v6, 4, v5
    v_xor_b32 v13, 0x80, v12
    v_lshlrev_b32 v6, 12, v1
    v_lshl_or_b32 v6, v2, 8, v6
    v_lshl_or_b32 v7, v3, 4, v6
    s_and_b32 s52, s2, 7
    s_lshr_b32 s42, s52, 1
    s_xor_b32 s52, s52, s42
    s_and_b32 s52, s52, 1
    s_lshr_b32 s41, s2, 3
    s_lshl_b32 s41, s41, 1
    s_or_b32 s41, s41, s52
    s_lshl_b32 s52, s41, 21
    s_lshl_b32 s53, s42, 14
    s_add_u32 s52, s52, s53
    s_sub_u32 s18, 0x200000, s53
    s_mov_b32 s22, s18
    s_mov_b32 s19, 0x20000
    s_mov_b32 s23, 0x20000
    s_mov_b32 s27, 0x20000
    s_mov_b32 s26, 0x100000
    s_lshl_b32 s53, s41, 14
    s_lshl_b32 s58, s40, 12
    s_mov_b32 s46, s58
    s_add_u32 s47, s58, 49152
    s_mov_b32 s44, 0
    s_mov_b32 s45, 0x40000000
    s_mov_b32 s43, 2
    s_mov_b32 s30, 0xc04000
    s_mov_b32 s31, 0x20000
    s_lshl_b32 s90, s41, 8
    s_add_u32 s90, s90, 0xc00000
    s_or_b32 s87, s40, s42
    s_waitcnt lgkmcnt(0)
    s_add_u32 s16, s6, s52
    s_addc_u32 s17, s7, 0
    s_add_u32 s20, s8, s52
    s_addc_u32 s21, s9, 0
    s_mov_b32 s24, s4
    s_mov_b32 s25, s5
    s_mov_b32 s28, s14
    s_mov_b32 s29, s15
    buffer_load_dwordx4 v[40:43], v7, s[24:27], s53 offen offset:0
    buffer_load_dwordx4 v[44:47], v7, s[24:27], s53 offen offset:64
    buffer_load_dwordx4 v[48:51], v7, s[24:27], s53 offen offset:128
    buffer_load_dwordx4 v[52:55], v7, s[24:27], s53 offen offset:192
    s_cmp_lg_u32 s87, 0
    s_cbranch_scc1 L_nohdr
    s_mov_b64 exec, 1
    buffer_load_dword v27, off, s[28:31], s90 offset:4 sc1
    s_mov_b64 exec, -1
L_nohdr:
L_fill:
    s_or_b32 m0, s47, 0x10000
    s_mov_b32 s47, s46
    buffer_load_dwordx4 v12, s[20:23], s45 offen offset:0 nt lds
    buffer_load_dwordx4 v13, s[20:23], s45 offen offset:1024 nt lds
    buffer_load_dwordx4 v12, s[20:23], s45 offen offset:2048 nt lds
    buffer_load_dwordx4 v13, s[20:23], s45 offen offset:3072 nt lds
    s_mov_b32 m0, s46
    s_mov_b32 s45, s44
    buffer_load_dwordx4 v8, s[16:19], s44 offen offset:0 nt lds
    buffer_load_dwordx4 v9, s[16:19], s44 offen offset:1024 nt lds
    buffer_load_dwordx4 v10, s[16:19], s44 offen offset:2048 nt lds
    buffer_load_dwordx4 v11, s[16:19], s44 offen offset:3072 nt lds
    s_add_u32 s46, s46, 16384
    s_add_u32 s44, s44, 65536
    s_and_b32 s46, s46, 0xffff
    s_sub_u32 s43, s43, 1
    s_cmp_lg_u32 s43, 0
    s_cbranch_scc1 L_fill
    v_lshlrev_b32 v6, 8, v2
    v_or_b32 v14, v6, v4
    v_xor_b32 v15, 64, v14
    v_xor_b32 v16, 128, v14
    v_xor_b32 v17, 192, v14
    v_lshrrev_b32 v5, 2, v2
    v_lshl_or_b32 v5, v3, 2, v5
    v_and_b32 v6, 7, v5
    v_lshlrev_b32 v6, 5, v6
    v_lshl_or_b32 v6, v5, 8, v6
    v_and_b32 v5, 3, v2
    v_lshl_or_b32 v6, v5, 3, v6
    v_xor_b32 v5, 0, v6
    v_add_u32 v18, 114688, v5
    v_xor_b32 v5, 32, v6
    v_add_u32 v19, 114688, v5
    v_xor_b32 v5, 64, v6
    v_add_u32 v20, 114688, v5
    v_xor_b32 v5, 96, v6
    v_add_u32 v21, 114688, v5
    v_xor_b32 v5, 128, v6
    v_add_u32 v22, 114688, v5
    v_xor_b32 v5, 160, v6
    v_add_u32 v23, 114688, v5
    v_xor_b32 v5, 192, v6
    v_add_u32 v24, 114688, v5
    v_xor_b32 v5, 224, v6
    v_add_u32 v25, 114688, v5
    v_mov_b32 v80, 0
    v_mov_b32 v81, 0
    v_mov_b32 v82, 0
    v_mov_b32 v83, 0
    v_mov_b32 v84, 0
    v_mov_b32 v85, 0
    v_mov_b32 v86, 0
    v_mov_b32 v87, 0
    v_mov_b32 v88, 0
    v_mov_b32 v89, 0
    v_mov_b32 v90, 0
    v_mov_b32 v91, 0
    v_mov_b32 v92, 0
    v_mov_b32 v93, 0
    v_mov_b32 v94, 0
    v_mov_b32 v95, 0
    v_mov_b32 v96, 0
    v_mov_b32 v97, 0
    v_mov_b32 v98, 0
    v_mov_b32 v99, 0
    v_mov_b32 v100, 0
    v_mov_b32 v101, 0
    v_mov_b32 v102, 0
    v_mov_b32 v103, 0
    v_mov_b32 v104, 0
    v_mov_b32 v105, 0
    v_mov_b32 v106, 0
    v_mov_b32 v107, 0
    v_mov_b32 v108, 0
    v_mov_b32 v109, 0
    v_mov_b32 v110, 0
    v_mov_b32 v111, 0
    v_mov_b32 v72, 0
    v_mov_b32 v73, 0
    v_mov_b32 v74, 0
    v_mov_b32 v75, 0
    v_mov_b32 v76, 0
    v_mov_b32 v77, 0
    v_mov_b32 v78, 0
    v_mov_b32 v79, 0
    v_mov_b32 v26, 0xff800000
    v_mov_b32 v28, 0
    v_mov_b32 v1, 1
    v_mov_b32 v3, 0x20000
    s_mov_b32 s50, 0x3e0293ee
    s_mov_b32 s54, 0x43800000
    s_mov_b32 s43, 0
    s_mov_b32 s59, -49152
    s_mov_b32 s63, 16384
    s_mov_b32 s49, -49152
    s_mov_b32 s32, s10
    s_mov_b32 s33, s11
    s_mov_b32 s34, 0x100000
    s_mov_b32 s35, 0x20000
    s_mov_b32 s36, s12
    s_mov_b32 s37, s13
    s_mov_b32 s38, 256
    s_mov_b32 s39, 0x20000
    s_lshl_b32 s91, s41, 2
    s_mov_b32 s82, 0
    s_mov_b32 s93, 0
    s_mov_b32 s84, 57
    s_mov_b32 s88, s44
    s_lshl_b32 s89, s42, 0
    s_sub_u32 s89, 96, s89
    s_cmp_eq_u32 s40, 0
    s_cselect_b32 s85, 21, -1
    s_lshl_b32 s52, s41, 2
    s_add_u32 s53, s52, s40
    s_lshl_b32 s53, s53, 2
    s_add_u32 s53, s53, s42
    s_mul_i32 s4, s53, 8448
    s_add_u32 s5, s4, 4096
    s_add_u32 s53, s52, s42
    s_mul_i32 s53, s53, 33792
    s_lshl_b32 s52, s40, 11
    s_add_u32 s86, s42, 1
    s_and_b32 s86, s86, 3
    s_mul_i32 s86, s86, 8448
    s_add_u32 s9, s53, s86
    s_add_u32 s6, s9, s52
    s_add_u32 s86, s42, 2
    s_and_b32 s86, s86, 3
    s_mul_i32 s86, s86, 8448
    s_add_u32 s10, s53, s86
    s_add_u32 s7, s10, s52
    s_add_u32 s86, s42, 3
    s_and_b32 s86, s86, 3
    s_mul_i32 s86, s86, 8448
    s_add_u32 s11, s53, s86
    s_add_u32 s8, s11, s52
    v_lshlrev_b32 v2, 4, v0
    v_and_b32 v5, 15, v0
    v_lshlrev_b32 v35, 4, v5
    v_add_u32 v35, 8192, v35
    v_add_u32 v36, 0x20040, v2
    v_lshlrev_b32 v37, 3, v5
    v_add_u32 v37, 0x22040, v37
    s_mov_b32 s13, 0x07060500
    s_mov_b32 s14, 0xff
    v_lshrrev_b32 v6, 4, v0
    v_lshlrev_b32 v5, 8, v5
    v_lshl_or_b32 v5, v6, 3, v5
    s_lshl_b32 s52, s40, 6
    v_add_u32 v5, s52, v5
    s_lshl_b32 s52, s41, 14
    s_lshl_b32 s53, s42, 12
    s_add_u32 s12, s52, s53
L_loop:
    s_waitcnt vmcnt(8)
    s_cmp_lg_u32 s93, 0
    s_cbranch_scc1 L_w4
L_w4ret:
    s_cmp_ge_u32 s43, s85
    s_cbranch_scc0 L_nb
    s_sub_u32 s52, s43, 22
    s_lshl_b64 exec, 1, s52
    ds_write_b32 v3, v1
    s_mov_b64 exec, -1
    s_waitcnt lgkmcnt(0)
L_nb:
    s_barrier
    ds_read_b32 v4, v3
    s_cmp_eq_u32 s43, s82
    s_cbranch_scc1 L_svc
L_svcret:
    s_cmp_ge_u32 s43, s85
    s_cbranch_scc0 L_na
    s_sub_u32 s52, s43, 21
    s_lshl_b64 exec, 1, s52
    buffer_atomic_add v1, off, s[28:31], s90 sc0
    s_mov_b64 exec, -1
L_na:
    s_add_u32 s43, s43, 1
    ds_read_b128 v[112:115], v14 offset:0
    ds_read_b128 v[116:119], v15 offset:0
    ds_read_b128 v[120:123], v16 offset:0
    ds_read_b128 v[124:127], v17 offset:0
    ds_read_b128 v[128:131], v14 offset:4096
    ds_read_b128 v[132:135], v15 offset:4096
    ds_read_b128 v[136:139], v16 offset:4096
    s_or_b32 m0, s47, 0x10000
    s_mov_b32 s47, s46
    s_cmp_ge_u32 s45, s22
    s_cbranch_scc1 L_vskip
    buffer_load_dwordx4 v12, s[20:23], s45 offen offset:0 nt lds
    buffer_load_dwordx4 v13, s[20:23], s45 offen offset:1024 nt lds
    buffer_load_dwordx4 v12, s[20:23], s45 offen offset:2048 nt lds
    buffer_load_dwordx4 v13, s[20:23], s45 offen offset:3072 nt lds
L_vskip:
    s_and_b32 s52, s43, 3
    s_cselect_b32 s48, s63, s59
    s_waitcnt lgkmcnt(5)
    v_mfma_f32_16x16x32_bf16 v[56:59], v[112:115], v[40:43], 0
    ds_read_b128 v[140:143], v17 offset:4096
    v_mfma_f32_16x16x32_bf16 v[56:59], v[116:119], v[44:47], v[56:59]
    ds_read_b64_tr_b16 v[176:177], v18 offset:0
    ds_read_b64_tr_b16 v[178:179], v18 offset:4096
    s_waitcnt lgkmcnt(6)
    v_mfma_f32_16x16x32_bf16 v[56:59], v[120:123], v[48:51], v[56:59]
    ds_read_b64_tr_b16 v[184:185], v19 offset:0
    ds_read_b64_tr_b16 v[186:187], v19 offset:4096
    v_readfirstlane_b32 s86, v4
    s_add_u32 s92, s43, 1
    s_mov_b32 m0, s46
    s_nop 1
    s_add_u32 s86, s86, s89
    s_lshl_b32 s86, s86, 14
    s_cmp_lt_u32 s92, 24
    s_cselect_b32 s44, s88, s86
    s_or_b32 s44, s44, s93
    s_add_u32 s88, s88, 65536
    s_cmp_ge_u32 s44, s18
    s_cbranch_scc1 L_kskip
    buffer_load_dwordx4 v8, s[16:19], s44 offen offset:0 nt lds
    buffer_load_dwordx4 v9, s[16:19], s44 offen offset:1024 nt lds
    buffer_load_dwordx4 v10, s[16:19], s44 offen offset:2048 nt lds
    buffer_load_dwordx4 v11, s[16:19], s44 offen offset:3072 nt lds
L_kdone:
    s_mov_b32 s45, s44
    s_add_u32 s46, s46, 16384
    s_and_b32 s46, s46, 0xffff
    v_mfma_f32_16x16x32_bf16 v[56:59], v[124:127], v[52:55], v[56:59]
    ds_read_b64_tr_b16 v[192:193], v20 offset:0
    ds_read_b64_tr_b16 v[194:195], v20 offset:4096
    v_xor_b32 v3, 4, v3
    s_waitcnt lgkmcnt(8)
    v_mfma_f32_16x16x32_bf16 v[60:63], v[128:131], v[40:43], 0
    ds_read_b64_tr_b16 v[200:201], v21 offset:0
    ds_read_b64_tr_b16 v[202:203], v21 offset:4096
    v_mfma_f32_16x16x32_bf16 v[60:63], v[132:135], v[44:47], v[60:63]
    ds_read_b64_tr_b16 v[208:209], v22 offset:0
    ds_read_b64_tr_b16 v[210:211], v22 offset:4096
    s_waitcnt lgkmcnt(10)
    v_mfma_f32_16x16x32_bf16 v[60:63], v[136:139], v[48:51], v[60:63]
    ds_read_b64_tr_b16 v[216:217], v23 offset:0
    ds_read_b64_tr_b16 v[218:219], v23 offset:4096
    v_mfma_f32_16x16x32_bf16 v[60:63], v[140:143], v[52:55], v[60:63]
    ds_read_b64_tr_b16 v[224:225], v24 offset:0
    ds_read_b64_tr_b16 v[226:227], v24 offset:4096
    s_waitcnt lgkmcnt(10)
    v_mfma_f32_16x16x32_bf16 v[80:83], v[176:179], v[72:75], v[80:83]
    ds_read_b64_tr_b16 v[232:233], v25 offset:0
    ds_read_b64_tr_b16 v[234:235], v25 offset:4096
    v_fma_f32 v240, v56, s50, -v26
    v_mfma_f32_16x16x32_bf16 v[84:87], v[184:187], v[72:75], v[84:87]
    ds_read_b128 v[144:147], v14 offset:8192
    v_exp_f32 v240, v240
    v_fma_f32 v241, v57, s50, -v26
    s_waitcnt lgkmcnt(9)
    v_mfma_f32_16x16x32_bf16 v[88:91], v[192:195], v[72:75], v[88:91]
    ds_read_b128 v[148:151], v15 offset:8192
    v_exp_f32 v241, v241
    v_fma_f32 v242, v58, s50, -v26
    v_mfma_f32_16x16x32_bf16 v[92:95], v[200:203], v[72:75], v[92:95]
    ds_read_b128 v[152:155], v16 offset:8192
    v_exp_f32 v242, v242
    v_fma_f32 v243, v59, s50, -v26
    s_waitcnt lgkmcnt(7)
    v_mfma_f32_16x16x32_bf16 v[96:99], v[208:211], v[72:75], v[96:99]
    ds_read_b128 v[156:159], v17 offset:8192
    v_exp_f32 v243, v243
    v_fma_f32 v244, v60, s50, -v26
    v_mfma_f32_16x16x32_bf16 v[100:103], v[216:219], v[72:75], v[100:103]
    ds_read_b128 v[160:163], v14 offset:12288
    v_exp_f32 v244, v244
    v_fma_f32 v245, v61, s50, -v26
    s_waitcnt lgkmcnt(5)
    v_mfma_f32_16x16x32_bf16 v[104:107], v[224:227], v[72:75], v[104:107]
    ds_read_b128 v[164:167], v15 offset:12288
    v_exp_f32 v245, v245
    v_fma_f32 v246, v62, s50, -v26
    v_mfma_f32_16x16x32_bf16 v[108:111], v[232:235], v[72:75], v[108:111]
    ds_read_b128 v[168:171], v16 offset:12288
    v_exp_f32 v246, v246
    v_fma_f32 v247, v63, s50, -v26
    s_waitcnt lgkmcnt(5)
    v_mfma_f32_16x16x32_bf16 v[64:67], v[144:147], v[40:43], 0
    ds_read_b128 v[172:175], v17 offset:12288
    v_exp_f32 v247, v247
    v_mfma_f32_16x16x32_bf16 v[64:67], v[148:151], v[44:47], v[64:67]
    ds_read_b64_tr_b16 v[180:181], v18 offset:8192
    ds_read_b64_tr_b16 v[182:183], v18 offset:12288
    v_add_f32 v30, v240, v241
    v_add_f32 v31, v242, v243
    v_add_u32 v14, s48, v14
    v_add_u32 v15, s48, v15
    s_waitcnt lgkmcnt(6)
    v_mfma_f32_16x16x32_bf16 v[64:67], v[152:155], v[48:51], v[64:67]
    ds_read_b64_tr_b16 v[188:189], v19 offset:8192
    ds_read_b64_tr_b16 v[190:191], v19 offset:12288
    v_add_f32 v32, v244, v245
    v_add_f32 v33, v246, v247
    v_add_u32 v16, s48, v16
    v_add_u32 v17, s48, v17
    v_add_u32 v18, s49, v18
    v_mfma_f32_16x16x32_bf16 v[64:67], v[156:159], v[52:55], v[64:67]
    ds_read_b64_tr_b16 v[196:197], v20 offset:8192
    ds_read_b64_tr_b16 v[198:199], v20 offset:12288
    v_cvt_pk_bf16_f32 v72, v240, v241
    v_cvt_pk_bf16_f32 v73, v242, v243
    v_add_u32 v19, s49, v19
    s_waitcnt lgkmcnt(8)
    v_mfma_f32_16x16x32_bf16 v[68:71], v[160:163], v[40:43], 0
    ds_read_b64_tr_b16 v[204:205], v21 offset:8192
    ds_read_b64_tr_b16 v[206:207], v21 offset:12288
    v_cvt_pk_bf16_f32 v74, v244, v245
    v_cvt_pk_bf16_f32 v75, v246, v247
    v_add_u32 v20, s49, v20
    v_mfma_f32_16x16x32_bf16 v[68:71], v[164:167], v[44:47], v[68:71]
    ds_read_b64_tr_b16 v[212:213], v22 offset:8192
    ds_read_b64_tr_b16 v[214:215], v22 offset:12288
    v_add_f32 v30, v30, v31
    v_add_f32 v32, v32, v33
    v_add_u32 v21, s49, v21
    s_waitcnt lgkmcnt(10)
    v_mfma_f32_16x16x32_bf16 v[68:71], v[168:171], v[48:51], v[68:71]
    ds_read_b64_tr_b16 v[220:221], v23 offset:8192
    ds_read_b64_tr_b16 v[222:223], v23 offset:12288
    v_add_f32 v30, v30, v32
    v_add_u32 v22, s49, v22
    v_mfma_f32_16x16x32_bf16 v[68:71], v[172:175], v[52:55], v[68:71]
    ds_read_b64_tr_b16 v[228:229], v24 offset:8192
    ds_read_b64_tr_b16 v[230:231], v24 offset:12288
    v_add_u32 v23, s49, v23
    s_waitcnt lgkmcnt(10)
    v_mfma_f32_16x16x32_bf16 v[80:83], v[180:183], v[76:79], v[80:83]
    ds_read_b64_tr_b16 v[236:237], v25 offset:8192
    ds_read_b64_tr_b16 v[238:239], v25 offset:12288
    v_fma_f32 v248, v64, s50, -v26
    v_add_u32 v24, s49, v24
    v_mfma_f32_16x16x32_bf16 v[84:87], v[188:191], v[76:79], v[84:87]
    v_exp_f32 v248, v248
    v_fma_f32 v249, v65, s50, -v26
    v_add_u32 v25, s49, v25
    s_waitcnt lgkmcnt(8)
    v_mfma_f32_16x16x32_bf16 v[88:91], v[196:199], v[76:79], v[88:91]
    v_exp_f32 v249, v249
    v_fma_f32 v250, v66, s50, -v26
    v_mfma_f32_16x16x32_bf16 v[92:95], v[204:207], v[76:79], v[92:95]
    v_exp_f32 v250, v250
    v_fma_f32 v251, v67, s50, -v26
    s_waitcnt lgkmcnt(4)
    v_mfma_f32_16x16x32_bf16 v[96:99], v[212:215], v[76:79], v[96:99]
    v_exp_f32 v251, v251
    v_fma_f32 v252, v68, s50, -v26
    v_mfma_f32_16x16x32_bf16 v[100:103], v[220:223], v[76:79], v[100:103]
    v_exp_f32 v252, v252
    v_fma_f32 v253, v69, s50, -v26
    s_waitcnt lgkmcnt(0)
    v_mfma_f32_16x16x32_bf16 v[104:107], v[228:231], v[76:79], v[104:107]
    v_exp_f32 v253, v253
    v_fma_f32 v254, v70, s50, -v26
    v_mfma_f32_16x16x32_bf16 v[108:111], v[236:239], v[76:79], v[108:111]
    v_exp_f32 v254, v254
    v_fma_f32 v255, v71, s50, -v26
    v_exp_f32 v255, v255
    v_add_f32 v31, v248, v249
    v_add_f32 v32, v250, v251
    v_add_f32 v33, v252, v253
    v_cvt_pk_bf16_f32 v76, v248, v249
    v_cvt_pk_bf16_f32 v77, v250, v251
    v_add_f32 v34, v254, v255
    v_add_f32 v30, v30, v31
    v_add_f32 v32, v32, v33
    v_cvt_pk_bf16_f32 v78, v252, v253
    v_add_f32 v30, v30, v34
    v_cvt_pk_bf16_f32 v79, v254, v255
    v_add_f32 v30, v30, v32
    v_cmp_nge_f32 vcc, s54, v30
    s_mov_b32 s49, s48
    s_cbranch_vccnz L_slow
L_back:
    v_add_f32 v28, v28, v30
    s_cmp_lt_u32 s43, s84
    s_cbranch_scc1 L_loop
    v_mov_b32 v31, v28
    v_mov_b32 v7, s83
    v_mov_b32 v30, v26
    v_permlane32_swap_b32 v31, v28
    v_mov_b32 v32, s83
    v_add_f32 v28, v28, v31
    v_mov_b32 v31, v28
    v_mov_b32 v33, s83
    s_nop 0
    v_permlane16_swap_b32 v31, v28
    v_add_f32 v31, v28, v31
    s_cmp_eq_u32 s40, s42
    s_cbranch_scc1 L_self
    s_waitcnt vmcnt(0)
    s_barrier
    ds_read_b64_tr_b16 v[176:177], v18 offset:0
    ds_read_b64_tr_b16 v[178:179], v18 offset:4096
    ds_read_b64_tr_b16 v[180:181], v18 offset:8192
    ds_read_b64_tr_b16 v[182:183], v18 offset:12288
    ds_read_b64_tr_b16 v[184:185], v19 offset:0
    ds_read_b64_tr_b16 v[186:187], v19 offset:4096
    ds_read_b64_tr_b16 v[188:189], v19 offset:8192
    ds_read_b64_tr_b16 v[190:191], v19 offset:12288
    ds_read_b64_tr_b16 v[192:193], v20 offset:0
    ds_read_b64_tr_b16 v[194:195], v20 offset:4096
    ds_read_b64_tr_b16 v[196:197], v20 offset:8192
    ds_read_b64_tr_b16 v[198:199], v20 offset:12288
    s_mov_b64 exec, 0xffff
    buffer_store_dwordx4 v[30:33], v35, s[28:31], s4 offen sc1
    s_mov_b64 exec, -1
    s_waitcnt lgkmcnt(10)
    v_mfma_f32_16x16x32_bf16 v[80:83], v[176:179], v[72:75], v[80:83]
    s_waitcnt lgkmcnt(8)
    v_mfma_f32_16x16x32_bf16 v[80:83], v[180:183], v[76:79], v[80:83]
    ds_read_b64_tr_b16 v[200:201], v21 offset:0
    ds_read_b64_tr_b16 v[202:203], v21 offset:4096
    ds_read_b64_tr_b16 v[204:205], v21 offset:8192
    ds_read_b64_tr_b16 v[206:207], v21 offset:12288
    s_waitcnt lgkmcnt(10)
    v_mfma_f32_16x16x32_bf16 v[84:87], v[184:187], v[72:75], v[84:87]
    s_waitcnt lgkmcnt(8)
    v_mfma_f32_16x16x32_bf16 v[84:87], v[188:191], v[76:79], v[84:87]
    ds_read_b64_tr_b16 v[208:209], v22 offset:0
    ds_read_b64_tr_b16 v[210:211], v22 offset:4096
    ds_read_b64_tr_b16 v[212:213], v22 offset:8192
    ds_read_b64_tr_b16 v[214:215], v22 offset:12288
    s_waitcnt lgkmcnt(10)
    v_mfma_f32_16x16x32_bf16 v[88:91], v[192:195], v[72:75], v[88:91]
    s_waitcnt lgkmcnt(8)
    v_mfma_f32_16x16x32_bf16 v[88:91], v[196:199], v[76:79], v[88:91]
    ds_read_b64_tr_b16 v[216:217], v23 offset:0
    ds_read_b64_tr_b16 v[218:219], v23 offset:4096
    ds_read_b64_tr_b16 v[220:221], v23 offset:8192
    ds_read_b64_tr_b16 v[222:223], v23 offset:12288
    v_perm_b32 v80, v80, v7, s13
    v_perm_b32 v81, v81, v7, s13
    v_perm_b32 v82, v82, v7, s13
    v_perm_b32 v83, v83, v7, s13
    buffer_store_dwordx4 v[80:83], v2, s[28:31], s4 offen offset:0 sc1
    s_waitcnt lgkmcnt(10)
    v_mfma_f32_16x16x32_bf16 v[92:95], v[200:203], v[72:75], v[92:95]
    s_waitcnt lgkmcnt(8)
    v_mfma_f32_16x16x32_bf16 v[92:95], v[204:207], v[76:79], v[92:95]
    ds_read_b64_tr_b16 v[224:225], v24 offset:0
    ds_read_b64_tr_b16 v[226:227], v24 offset:4096
    ds_read_b64_tr_b16 v[228:229], v24 offset:8192
    ds_read_b64_tr_b16 v[230:231], v24 offset:12288
    v_perm_b32 v84, v84, v7, s13
    v_perm_b32 v85, v85, v7, s13
    v_perm_b32 v86, v86, v7, s13
    v_perm_b32 v87, v87, v7, s13
    buffer_store_dwordx4 v[84:87], v2, s[28:31], s4 offen offset:1024 sc1
    s_waitcnt lgkmcnt(10)
    v_mfma_f32_16x16x32_bf16 v[96:99], v[208:211], v[72:75], v[96:99]
    s_waitcnt lgkmcnt(8)
    v_mfma_f32_16x16x32_bf16 v[96:99], v[212:215], v[76:79], v[96:99]
    ds_read_b64_tr_b16 v[232:233], v25 offset:0
    ds_read_b64_tr_b16 v[234:235], v25 offset:4096
    ds_read_b64_tr_b16 v[236:237], v25 offset:8192
    ds_read_b64_tr_b16 v[238:239], v25 offset:12288
    v_perm_b32 v88, v88, v7, s13
    v_perm_b32 v89, v89, v7, s13
    v_perm_b32 v90, v90, v7, s13
    v_perm_b32 v91, v91, v7, s13
    buffer_store_dwordx4 v[88:91], v2, s[28:31], s4 offen offset:2048 sc1
    s_waitcnt lgkmcnt(10)
    v_mfma_f32_16x16x32_bf16 v[100:103], v[216:219], v[72:75], v[100:103]
    s_waitcnt lgkmcnt(8)
    v_mfma_f32_16x16x32_bf16 v[100:103], v[220:223], v[76:79], v[100:103]
    v_perm_b32 v92, v92, v7, s13
    v_perm_b32 v93, v93, v7, s13
    v_perm_b32 v94, v94, v7, s13
    v_perm_b32 v95, v95, v7, s13
    buffer_store_dwordx4 v[92:95], v2, s[28:31], s4 offen offset:3072 sc1
    s_waitcnt lgkmcnt(6)
    v_mfma_f32_16x16x32_bf16 v[104:107], v[224:227], v[72:75], v[104:107]
    s_waitcnt lgkmcnt(4)
    v_mfma_f32_16x16x32_bf16 v[104:107], v[228:231], v[76:79], v[104:107]
    v_perm_b32 v96, v96, v7, s13
    v_perm_b32 v97, v97, v7, s13
    v_perm_b32 v98, v98, v7, s13
    v_perm_b32 v99, v99, v7, s13
    buffer_store_dwordx4 v[96:99], v2, s[28:31], s5 offen offset:0 sc1
    s_waitcnt lgkmcnt(2)
    v_mfma_f32_16x16x32_bf16 v[108:111], v[232:235], v[72:75], v[108:111]
    s_waitcnt lgkmcnt(0)
    v_mfma_f32_16x16x32_bf16 v[108:111], v[236:239], v[76:79], v[108:111]
    v_perm_b32 v100, v100, v7, s13
    v_perm_b32 v101, v101, v7, s13
    v_perm_b32 v102, v102, v7, s13
    v_perm_b32 v103, v103, v7, s13
    buffer_store_dwordx4 v[100:103], v2, s[28:31], s5 offen offset:1024 sc1
    v_perm_b32 v104, v104, v7, s13
    v_perm_b32 v105, v105, v7, s13
    v_perm_b32 v106, v106, v7, s13
    v_perm_b32 v107, v107, v7, s13
    buffer_store_dwordx4 v[104:107], v2, s[28:31], s5 offen offset:2048 sc1
    v_perm_b32 v108, v108, v7, s13
    v_perm_b32 v109, v109, v7, s13
    v_perm_b32 v110, v110, v7, s13
    v_perm_b32 v111, v111, v7, s13
    buffer_store_dwordx4 v[108:111], v2, s[28:31], s5 offen offset:3072 sc1
    s_branch L_pubd
L_self:
    s_waitcnt vmcnt(0)
    s_barrier
    s_mov_b64 exec, 0xffff
    ds_write_b64 v37, v[30:31]
    s_mov_b64 exec, -1
    ds_read_b64_tr_b16 v[176:177], v18 offset:0
    ds_read_b64_tr_b16 v[178:179], v18 offset:4096
    ds_read_b64_tr_b16 v[180:181], v18 offset:8192
    ds_read_b64_tr_b16 v[182:183], v18 offset:12288
    ds_read_b64_tr_b16 v[184:185], v19 offset:0
    ds_read_b64_tr_b16 v[186:187], v19 offset:4096
    ds_read_b64_tr_b16 v[188:189], v19 offset:8192
    ds_read_b64_tr_b16 v[190:191], v19 offset:12288
    ds_read_b64_tr_b16 v[192:193], v20 offset:0
    ds_read_b64_tr_b16 v[194:195], v20 offset:4096
    ds_read_b64_tr_b16 v[196:197], v20 offset:8192
    ds_read_b64_tr_b16 v[198:199], v20 offset:12288
    s_waitcnt lgkmcnt(10)
    v_mfma_f32_16x16x32_bf16 v[80:83], v[176:179], v[72:75], v[80:83]
    s_waitcnt lgkmcnt(8)
    v_mfma_f32_16x16x32_bf16 v[80:83], v[180:183], v[76:79], v[80:83]
    ds_read_b64_tr_b16 v[200:201], v21 offset:0
    ds_read_b64_tr_b16 v[202:203], v21 offset:4096
    ds_read_b64_tr_b16 v[204:205], v21 offset:8192
    ds_read_b64_tr_b16 v[206:207], v21 offset:12288
    s_waitcnt lgkmcnt(10)
    v_mfma_f32_16x16x32_bf16 v[84:87], v[184:187], v[72:75], v[84:87]
    s_waitcnt lgkmcnt(8)
    v_mfma_f32_16x16x32_bf16 v[84:87], v[188:191], v[76:79], v[84:87]
    ds_read_b64_tr_b16 v[208:209], v22 offset:0
    ds_read_b64_tr_b16 v[210:211], v22 offset:4096
    ds_read_b64_tr_b16 v[212:213], v22 offset:8192
    ds_read_b64_tr_b16 v[214:215], v22 offset:12288
    s_waitcnt lgkmcnt(10)
    v_mfma_f32_16x16x32_bf16 v[88:91], v[192:195], v[72:75], v[88:91]
    s_waitcnt lgkmcnt(8)
    v_mfma_f32_16x16x32_bf16 v[88:91], v[196:199], v[76:79], v[88:91]
    ds_read_b64_tr_b16 v[216:217], v23 offset:0
    ds_read_b64_tr_b16 v[218:219], v23 offset:4096
    ds_read_b64_tr_b16 v[220:221], v23 offset:8192
    ds_read_b64_tr_b16 v[222:223], v23 offset:12288
    ds_write_b128 v36, v[80:83] offset:0
    s_waitcnt lgkmcnt(11)
    v_mfma_f32_16x16x32_bf16 v[92:95], v[200:203], v[72:75], v[92:95]
    s_waitcnt lgkmcnt(9)
    v_mfma_f32_16x16x32_bf16 v[92:95], v[204:207], v[76:79], v[92:95]
    ds_read_b64_tr_b16 v[224:225], v24 offset:0
    ds_read_b64_tr_b16 v[226:227], v24 offset:4096
    ds_read_b64_tr_b16 v[228:229], v24 offset:8192
    ds_read_b64_tr_b16 v[230:231], v24 offset:12288
    ds_write_b128 v36, v[84:87] offset:1024
    s_waitcnt lgkmcnt(12)
    v_mfma_f32_16x16x32_bf16 v[96:99], v[208:211], v[72:75], v[96:99]
    s_waitcnt lgkmcnt(10)
    v_mfma_f32_16x16x32_bf16 v[96:99], v[212:215], v[76:79], v[96:99]
    ds_read_b64_tr_b16 v[232:233], v25 offset:0
    ds_read_b64_tr_b16 v[234:235], v25 offset:4096
    ds_read_b64_tr_b16 v[236:237], v25 offset:8192
    ds_read_b64_tr_b16 v[238:239], v25 offset:12288
    ds_write_b128 v36, v[88:91] offset:2048
    s_waitcnt lgkmcnt(13)
    v_mfma_f32_16x16x32_bf16 v[100:103], v[216:219], v[72:75], v[100:103]
    s_waitcnt lgkmcnt(11)
    v_mfma_f32_16x16x32_bf16 v[100:103], v[220:223], v[76:79], v[100:103]
    ds_write_b128 v36, v[92:95] offset:3072
    s_waitcnt lgkmcnt(9)
    v_mfma_f32_16x16x32_bf16 v[104:107], v[224:227], v[72:75], v[104:107]
    s_waitcnt lgkmcnt(7)
    v_mfma_f32_16x16x32_bf16 v[104:107], v[228:231], v[76:79], v[104:107]
    ds_write_b128 v36, v[96:99] offset:4096
    s_waitcnt lgkmcnt(5)
    v_mfma_f32_16x16x32_bf16 v[108:111], v[232:235], v[72:75], v[108:111]
    s_waitcnt lgkmcnt(3)
    v_mfma_f32_16x16x32_bf16 v[108:111], v[236:239], v[76:79], v[108:111]
    ds_write_b128 v36, v[100:103] offset:5120
    s_nop 7
    ds_write_b128 v36, v[104:107] offset:6144
    ds_write_b128 v36, v[108:111] offset:7168
    s_waitcnt lgkmcnt(0)
L_pubd:
    s_mov_b32 s48, 14
    s_mov_b32 s49, 0
    s_lshl_b32 s52, s40, 11
    v_add_u32 v36, s52, v36
L_poll:
    s_bitcmp1_b32 s48, 1
    s_cbranch_scc0 L_pl1
    buffer_load_dwordx4 v[176:179], v2, s[28:31], s6 offen offset:0 sc1
    buffer_load_dwordx4 v[180:183], v2, s[28:31], s6 offen offset:1024 sc1
    buffer_load_dwordx4 v[184:187], v35, s[28:31], s9 offen sc1
L_pl1:
    s_bitcmp1_b32 s48, 2
    s_cbranch_scc0 L_pl2
    buffer_load_dwordx4 v[188:191], v2, s[28:31], s7 offen offset:0 sc1
    buffer_load_dwordx4 v[192:195], v2, s[28:31], s7 offen offset:1024 sc1
    buffer_load_dwordx4 v[196:199], v35, s[28:31], s10 offen sc1
L_pl2:
    s_bitcmp1_b32 s48, 3
    s_cbranch_scc0 L_pl3
    buffer_load_dwordx4 v[200:203], v2, s[28:31], s8 offen offset:0 sc1
    buffer_load_dwordx4 v[204:207], v2, s[28:31], s8 offen offset:1024 sc1
    buffer_load_dwordx4 v[208:211], v35, s[28:31], s11 offen sc1
L_pl3:
    s_cmp_lg_u32 s49, 0
    s_cbranch_scc1 L_pw
    s_barrier
    ds_read_b128 v[112:115], v36
    ds_read_b128 v[116:119], v36 offset:1024
    ds_read_b64 v[120:121], v37
L_pw:
    s_add_u32 s49, s49, 1
    s_waitcnt vmcnt(0) lgkmcnt(0)
    s_bitcmp1_b32 s48, 1
    s_cbranch_scc0 L_pm1
    v_bitop3_b32 v240, v176, v177, v7 bitop3:0x7e
    v_bitop3_b32 v241, v178, v179, v7 bitop3:0x7e
    v_bitop3_b32 v242, v180, v181, v7 bitop3:0x7e
    v_bitop3_b32 v243, v182, v183, v7 bitop3:0x7e
    v_xor_b32 v244, v7, v186
    v_or3_b32 v240, v240, v241, v242
    v_or_b32 v240, v240, v243
    v_and_or_b32 v240, v240, s14, v244
    v_cmp_ne_u32 vcc, 0, v240
    s_cbranch_vccnz L_pm1
    v_max_f32 v30, v120, v184
    s_bitset0_b32 s48, 1
    v_sub_f32 v31, v120, v30
    v_sub_f32 v32, v184, v30
    v_exp_f32 v31, v31
    v_exp_f32 v32, v32
    v_mov_b32 v120, v30
    v_mul_f32 v121, v31, v121
    v_mul_f32 v112, v31, v112
    v_mul_f32 v113, v31, v113
    v_mul_f32 v114, v31, v114
    v_mul_f32 v115, v31, v115
    v_mul_f32 v116, v31, v116
    v_mul_f32 v117, v31, v117
    v_mul_f32 v118, v31, v118
    v_mul_f32 v119, v31, v119
    v_fma_f32 v121, v32, v185, v121
    v_fma_f32 v112, v32, v176, v112
    v_fma_f32 v113, v32, v177, v113
    v_fma_f32 v114, v32, v178, v114
    v_fma_f32 v115, v32, v179, v115
    v_fma_f32 v116, v32, v180, v116
    v_fma_f32 v117, v32, v181, v117
    v_fma_f32 v118, v32, v182, v118
    v_fma_f32 v119, v32, v183, v119
L_pm1:
    s_bitcmp1_b32 s48, 2
    s_cbranch_scc0 L_pm2
    v_bitop3_b32 v240, v188, v189, v7 bitop3:0x7e
    v_bitop3_b32 v241, v190, v191, v7 bitop3:0x7e
    v_bitop3_b32 v242, v192, v193, v7 bitop3:0x7e
    v_bitop3_b32 v243, v194, v195, v7 bitop3:0x7e
    v_xor_b32 v244, v7, v198
    v_or3_b32 v240, v240, v241, v242
    v_or_b32 v240, v240, v243
    v_and_or_b32 v240, v240, s14, v244
    v_cmp_ne_u32 vcc, 0, v240
    s_cbranch_vccnz L_pm2
    v_max_f32 v30, v120, v196
    s_bitset0_b32 s48, 2
    v_sub_f32 v31, v120, v30
    v_sub_f32 v32, v196, v30
    v_exp_f32 v31, v31
    v_exp_f32 v32, v32
    v_mov_b32 v120, v30
    v_mul_f32 v121, v31, v121
    v_mul_f32 v112, v31, v112
    v_mul_f32 v113, v31, v113
    v_mul_f32 v114, v31, v114
    v_mul_f32 v115, v31, v115
    v_mul_f32 v116, v31, v116
    v_mul_f32 v117, v31, v117
    v_mul_f32 v118, v31, v118
    v_mul_f32 v119, v31, v119
    v_fma_f32 v121, v32, v197, v121
    v_fma_f32 v112, v32, v188, v112
    v_fma_f32 v113, v32, v189, v113
    v_fma_f32 v114, v32, v190, v114
    v_fma_f32 v115, v32, v191, v115
    v_fma_f32 v116, v32, v192, v116
    v_fma_f32 v117, v32, v193, v117
    v_fma_f32 v118, v32, v194, v118
    v_fma_f32 v119, v32, v195, v119
L_pm2:
    s_bitcmp1_b32 s48, 3
    s_cbranch_scc0 L_pm3
    v_bitop3_b32 v240, v200, v201, v7 bitop3:0x7e
    v_bitop3_b32 v241, v202, v203, v7 bitop3:0x7e
    v_bitop3_b32 v242, v204, v205, v7 bitop3:0x7e
    v_bitop3_b32 v243, v206, v207, v7 bitop3:0x7e
    v_xor_b32 v244, v7, v210
    v_or3_b32 v240, v240, v241, v242
    v_or_b32 v240, v240, v243
    v_and_or_b32 v240, v240, s14, v244
    v_cmp_ne_u32 vcc, 0, v240
    s_cbranch_vccnz L_pm3
    v_max_f32 v30, v120, v208
    s_bitset0_b32 s48, 3
    v_sub_f32 v31, v120, v30
    v_sub_f32 v32, v208, v30
    v_exp_f32 v31, v31
    v_exp_f32 v32, v32
    v_mov_b32 v120, v30
    v_mul_f32 v121, v31, v121
    v_mul_f32 v112, v31, v112
    v_mul_f32 v113, v31, v113
    v_mul_f32 v114, v31, v114
    v_mul_f32 v115, v31, v115
    v_mul_f32 v116, v31, v116
    v_mul_f32 v117, v31, v117
    v_mul_f32 v118, v31, v118
    v_mul_f32 v119, v31, v119
    v_fma_f32 v121, v32, v209, v121
    v_fma_f32 v112, v32, v200, v112
    v_fma_f32 v113, v32, v201, v113
    v_fma_f32 v114, v32, v202, v114
    v_fma_f32 v115, v32, v203, v115
    v_fma_f32 v116, v32, v204, v116
    v_fma_f32 v117, v32, v205, v117
    v_fma_f32 v118, v32, v206, v118
    v_fma_f32 v119, v32, v207, v119
L_pm3:
    s_cmp_eq_u32 s48, 0
    s_cbranch_scc1 L_polled
    s_cmp_lt_u32 s49, 0x8000
    s_cbranch_scc1 L_poll
L_polled:
    v_rcp_f32 v31, v121
    s_nop 0
    v_mul_f32 v56, v31, v112
    v_mul_f32 v57, v31, v113
    v_mul_f32 v58, v31, v114
    v_mul_f32 v59, v31, v115
    v_mul_f32 v60, v31, v116
    v_mul_f32 v61, v31, v117
    v_mul_f32 v62, v31, v118
    v_mul_f32 v63, v31, v119
    v_cvt_pk_bf16_f32 v72, v56, v57
    v_cvt_pk_bf16_f32 v73, v58, v59
    v_cvt_pk_bf16_f32 v74, v60, v61
    v_cvt_pk_bf16_f32 v75, v62, v63
    buffer_store_dwordx2 v[72:73], v5, s[32:35], s12 offen offset:0
    buffer_store_dwordx2 v[74:75], v5, s[32:35], s12 offen offset:32
L_done:
    s_endpgm
L_w4:
    s_waitcnt vmcnt(4)
    s_branch L_w4ret
L_kskip:
    s_min_u32 s84, s84, s92
    s_mov_b32 s93, 0x40000000
    s_mov_b32 s85, -1
    s_branch L_kdone
L_svc:
    s_cmp_eq_u32 s43, 0
    s_cbranch_scc1 L_svcB
    s_cmp_eq_u32 s43, 3
    s_cbranch_scc1 L_svcC
    s_cmp_eq_u32 s43, 11
    s_cbranch_scc1 L_svcD
    s_mov_b32 s82, -1
    v_readfirstlane_b32 s83, v27
    s_mov_b32 s52, 0
    s_nop 2
    s_cmp_lg_u32 s83, 0
    s_cbranch_scc1 L_svcret
L_spin:
    buffer_load_dword v27, off, s[36:39], s91 sc1
    s_add_u32 s52, s52, 1
    s_waitcnt vmcnt(0)
    v_readfirstlane_b32 s83, v27
    s_cmp_ge_u32 s52, 0x8000
    s_cbranch_scc1 L_svcret
    s_nop 1
    s_cmp_eq_u32 s83, 0
    s_cbranch_scc1 L_spin
    s_branch L_svcret
L_svcB:
    s_mov_b32 s82, 3
    s_cmp_lg_u32 s87, 0
    s_cbranch_scc1 L_svcret
    v_readfirstlane_b32 s83, v27
    v_mov_b32 v6, 0
    s_nop 2
    s_add_u32 s83, s83, 1
    s_addc_u32 s83, s83, 0
    v_mov_b32 v7, s83
    s_mov_b64 exec, 1
    buffer_store_dwordx2 v[6:7], off, s[28:31], s90 sc1
    s_mov_b64 exec, -1
    s_branch L_svcret
L_svcC:
    s_mov_b32 s82, 11
    s_cmp_lg_u32 s87, 0
    s_cbranch_scc1 L_svcret
    s_mov_b64 exec, 1
    buffer_store_dword v7, off, s[36:39], s91 sc1
    s_mov_b64 exec, -1
    s_branch L_svcret
L_svcD:
    s_mov_b32 s82, 14
    s_mov_b64 exec, 1
    buffer_load_dword v27, off, s[36:39], s91 sc1
    s_mov_b64 exec, -1
    s_branch L_svcret
L_slow:
    s_nop 7
    v_max3_f32 v30, v56, v57, v58
    v_max3_f32 v31, v59, v60, v61
    v_max3_f32 v32, v62, v63, v64
    v_max3_f32 v30, v30, v65, v66
    v_max3_f32 v31, v31, v67, v68
    v_max3_f32 v32, v32, v69, v70
    v_max3_f32 v30, v30, v31, v71
    v_max_f32 v30, v30, v32
    v_mov_b32 v31, v30
    s_nop 1
    v_permlane32_swap_b32 v31, v30
    v_max_f32 v30, v30, v31
    v_mov_b32 v31, v30
    s_nop 1
    v_permlane16_swap_b32 v31, v30
    v_max_f32 v30, v30, v31
    v_mul_f32 v30, s50, v30
    v_max_f32 v30, v30, v26
    v_sub_f32 v31, v26, v30
    v_mov_b32 v26, v30
    v_exp_f32 v29, v31
    v_fma_f32 v240, v56, s50, -v26
    v_fma_f32 v241, v57, s50, -v26
    v_fma_f32 v242, v58, s50, -v26
    v_fma_f32 v243, v59, s50, -v26
    v_fma_f32 v244, v60, s50, -v26
    v_fma_f32 v245, v61, s50, -v26
    v_fma_f32 v246, v62, s50, -v26
    v_fma_f32 v247, v63, s50, -v26
    v_fma_f32 v248, v64, s50, -v26
    v_fma_f32 v249, v65, s50, -v26
    v_fma_f32 v250, v66, s50, -v26
    v_fma_f32 v251, v67, s50, -v26
    v_fma_f32 v252, v68, s50, -v26
    v_fma_f32 v253, v69, s50, -v26
    v_fma_f32 v254, v70, s50, -v26
    v_fma_f32 v255, v71, s50, -v26
    v_exp_f32 v240, v240
    v_exp_f32 v241, v241
    v_exp_f32 v242, v242
    v_exp_f32 v243, v243
    v_exp_f32 v244, v244
    v_exp_f32 v245, v245
    v_exp_f32 v246, v246
    v_exp_f32 v247, v247
    v_exp_f32 v248, v248
    v_exp_f32 v249, v249
    v_exp_f32 v250, v250
    v_exp_f32 v251, v251
    v_exp_f32 v252, v252
    v_exp_f32 v253, v253
    v_exp_f32 v254, v254
    v_exp_f32 v255, v255
    v_mul_f32 v28, v29, v28
    v_mul_f32 v80, v29, v80
    v_mul_f32 v81, v29, v81
    v_mul_f32 v82, v29, v82
    v_mul_f32 v83, v29, v83
    v_mul_f32 v84, v29, v84
    v_mul_f32 v85, v29, v85
    v_mul_f32 v86, v29, v86
    v_mul_f32 v87, v29, v87
    v_mul_f32 v88, v29, v88
    v_mul_f32 v89, v29, v89
    v_mul_f32 v90, v29, v90
    v_mul_f32 v91, v29, v91
    v_mul_f32 v92, v29, v92
    v_mul_f32 v93, v29, v93
    v_mul_f32 v94, v29, v94
    v_mul_f32 v95, v29, v95
    v_mul_f32 v96, v29, v96
    v_mul_f32 v97, v29, v97
    v_mul_f32 v98, v29, v98
    v_mul_f32 v99, v29, v99
    v_mul_f32 v100, v29, v100
    v_mul_f32 v101, v29, v101
    v_mul_f32 v102, v29, v102
    v_mul_f32 v103, v29, v103
    v_mul_f32 v104, v29, v104
    v_mul_f32 v105, v29, v105
    v_mul_f32 v106, v29, v106
    v_mul_f32 v107, v29, v107
    v_mul_f32 v108, v29, v108
    v_mul_f32 v109, v29, v109
    v_mul_f32 v110, v29, v110
    v_mul_f32 v111, v29, v111
    v_add_f32 v30, v240, v241
    v_add_f32 v30, v30, v242
    v_add_f32 v30, v30, v243
    v_add_f32 v30, v30, v244
    v_add_f32 v30, v30, v245
    v_add_f32 v30, v30, v246
    v_add_f32 v30, v30, v247
    v_add_f32 v30, v30, v248
    v_add_f32 v30, v30, v249
    v_add_f32 v30, v30, v250
    v_add_f32 v30, v30, v251
    v_add_f32 v30, v30, v252
    v_add_f32 v30, v30, v253
    v_add_f32 v30, v30, v254
    v_add_f32 v30, v30, v255
    v_cvt_pk_bf16_f32 v72, v240, v241
    v_cvt_pk_bf16_f32 v73, v242, v243
    v_cvt_pk_bf16_f32 v74, v244, v245
    v_cvt_pk_bf16_f32 v75, v246, v247
    v_cvt_pk_bf16_f32 v76, v248, v249
    v_cvt_pk_bf16_f32 v77, v250, v251
    v_cvt_pk_bf16_f32 v78, v252, v253
    v_cvt_pk_bf16_f32 v79, v254, v255
    s_branch L_back
.section .rodata,"a"
.p2align 6
.amdhsa_kernel standalone__gqa_softmax__sampling_kernel
  .amdhsa_next_free_vgpr 256
  .amdhsa_next_free_sgpr 96
  .amdhsa_accum_offset 256
  .amdhsa_group_segment_fixed_size 0
  .amdhsa_kernarg_size 48
  .amdhsa_user_sgpr_count 2
  .amdhsa_user_sgpr_kernarg_segment_ptr 1
  .amdhsa_system_sgpr_workgroup_id_x 1
.end_amdhsa_kernel
```
